```python
import torch

def _softmax(x, axis=-1):
    return torch.softmax(x, dim=axis)
def _gelu(x):
    return torch.nn.functional.gelu(x, approximate="tanh")
def _silu(x):
    return torch.nn.functional.silu(x)
def _sigmoid(x):
    return torch.sigmoid(x)
def _layernorm(x, axis=-1, eps=1e-5):
    m = x.mean(dim=axis, keepdim=True)
    v = x.var(dim=axis, keepdim=True, unbiased=False)
    return (x - m) / torch.sqrt(v + eps)
def _scatter_add(tgt, idx, src, axis=0):
    return tgt.clone().index_add_(axis, idx, src)
def _segment_sum(src, seg, n):
    out = torch.zeros((n,) + src.shape[1:], dtype=src.dtype)
    return out.index_add_(0, seg, src)
def _pad(x, pw):
    flat = tuple(v for pair in reversed(pw) for v in pair)
    return torch.nn.functional.pad(x, flat)

kernel_name = 'gated_mix__mha_block_cached__dense_activation_relu__decode'

def setup_inputs():

    _w = (lambda a: (lambda t: t.to(torch.bfloat16) if t.is_floating_point() else t)(torch.as_tensor(a)))
    def _A_setup():
        B, Sq, D = 2, 1, 448
        H, Sk, Dh = 16, 4096, 256
        return {
            "x": _w((lambda *s: torch.randn(*s, dtype=torch.bfloat16) * 0.05)(B, Sq, D)),
            "k_cache": _w((lambda *s: torch.randn(*s, dtype=torch.bfloat16) * 6.4)(B, H, Sk, Dh)),
            "v_cache": _w((lambda *s: torch.randn(*s, dtype=torch.bfloat16) * 0.4)(B, H, Sk, Dh)),
            "wq": _w((lambda *s: torch.randn(*s, dtype=torch.bfloat16) * 6.4)(D, H * Dh) * (D ** -0.5)),
            "wo": _w((lambda *s: torch.randn(*s, dtype=torch.bfloat16) * 0.4)(H * Dh, D) * ((H * Dh) ** -0.5)),
        }
    _A_in = _A_setup()

    def _B_setup():
        B, S, D, Dff = 2, 1, 448, 1792
        return {
            "x": _w((lambda *s: torch.randn(*s, dtype=torch.bfloat16) * 0.05)(B, S, D)),
            "w1": _w((lambda *s: torch.randn(*s, dtype=torch.bfloat16) * 0.05)(D, Dff)),
            "w2": _w((lambda *s: torch.randn(*s, dtype=torch.bfloat16) * 0.05)(Dff, D)),
        }
    _B_in = _B_setup()

    return {
        "A_x": _A_in["x"],
        "A_k_cache": _A_in["k_cache"],
        "A_v_cache": _A_in["v_cache"],
        "A_wq": _A_in["wq"],
        "A_wo": _A_in["wo"],
        "B_x": _B_in["x"],
        "B_w1": _B_in["w1"],
        "B_w2": _B_in["w2"],
        "gate_w": _w((lambda *s: torch.randn(*s, dtype=torch.bfloat16) * 0.05)(448) * 16.0),
    }

def reference(A_x, A_k_cache, A_v_cache, A_wq, A_wo, B_x, B_w1, B_w2, gate_w):
    def _A_ref(x, k_cache, v_cache, wq, wo):
        B, Sq, D = x.shape
        H, Dh = 16, 256
        q = (lambda x, *d: x.permute(*d))((x @ wq).reshape(B, Sq, H, Dh), 0, 2, 1, 3)
        scores = torch.einsum("bhqd,bhkd->bhqk", q, k_cache) * (Dh ** -0.5)
        p = _softmax(scores, axis=-1)
        o = torch.einsum("bhqk,bhkd->bhqd", p, v_cache)
        return (lambda x, *d: x.permute(*d))(o, 0, 2, 1, 3).reshape(B, Sq, H * Dh) @ wo

    def _B_ref(x, w1, w2):
        h = torch.einsum("bsd,df->bsf", x, w1)
        zero = torch.zeros_like(h)
        h = torch.maximum(h, zero)
        return torch.einsum("bsf,fd->bsd", h, w2)

    x = A_x
    g = _sigmoid((x * gate_w).sum(-1, keepdims=True))
    a = _A_ref(x, A_k_cache, A_v_cache, A_wq, A_wo)
    b = _B_ref(x, B_w1, B_w2)
    return g * a + (1 - g) * b
```

```asm
; @launch grid=(256,1,1) block=(576,1,1) lds=49152
.amdgcn_target "amdgcn-amd-amdhsa--gfx950"
.text
.globl gated_mix__mha_block_cached__dense_activation_relu__decode_kernel
.p2align 8
.type gated_mix__mha_block_cached__dense_activation_relu__decode_kernel,@function
gated_mix__mha_block_cached__dense_activation_relu__decode_kernel:
  s_cmp_ge_u32 s2, 256
  s_cbranch_scc1 L_end
  s_load_dwordx16 s[16:31], s[0:1], 0
  s_load_dwordx8 s[32:39], s[0:1], 64
  v_lshrrev_b32 v2, 6, v0
  v_and_b32 v1, 63, v0
  v_readfirstlane_b32 s3, v2
  s_and_b32 s14, s2, 7
  s_lshr_b32 s15, s2, 3
  s_lshr_b32 s4, s15, 4
  s_bfe_u32 s5, s15, 0x10003
  s_lshl_b32 s14, s14, 1
  s_add_u32 s5, s5, s14
  s_and_b32 s6, s15, 7
  s_lshl_b32 s7, s4, 4
  s_add_u32 s7, s7, s5
  s_lshl_b32 s10, s5, 3
  s_add_u32 s10, s10, s6
  s_cmp_eq_u32 s3, 0
  s_cbranch_scc1 L_service
  s_sub_u32 s3, s3, 1
  v_bfe_u32 v6, v1, 2, 2
  v_lshlrev_b32 v2, 9, v6
  v_lshrrev_b32 v6, 4, v1
  v_lshl_add_u32 v2, v6, 6, v2
  v_and_b32 v6, 3, v1
  v_lshl_add_u32 v2, v6, 4, v2
  s_lshl_b32 s8, s7, 21
  s_bfe_u32 s14, s3, 0x30000
  s_lshl_b32 s14, s14, 12
  s_add_u32 s8, s8, s14
  s_bfe_u32 s14, s6, 0x30000
  s_lshl_b32 s14, s14, 18
  s_add_u32 s8, s8, s14
  v_add_u32 v2, s8, v2
  s_waitcnt lgkmcnt(0)
  s_mov_b32 s40, s18
  s_mov_b32 s41, s19
  s_mov_b32 s42, 67108864
  s_mov_b32 s43, 0x20000
  buffer_load_dwordx4 v[36:39], v2, s[40:43], 0 offen offset:0 nt
  buffer_load_dwordx4 v[40:43], v2, s[40:43], 0 offen offset:256 nt
  buffer_load_dwordx4 v[44:47], v2, s[40:43], 0 offen offset:2048 nt
  s_mov_b32 s44, s20
  s_mov_b32 s45, s21
  s_mov_b32 s46, 67108864
  s_mov_b32 s47, 0x20000
  s_mov_b32 s48, s24
  s_mov_b32 s49, s25
  s_mov_b32 s50, 3670016
  s_mov_b32 s51, 0x20000
  s_mov_b32 s64, s30
  s_mov_b32 s65, s31
  s_mov_b32 s66, 1605632
  s_mov_b32 s67, 0x20000
  s_mov_b32 s52, s38
  s_mov_b32 s53, s39
  s_mov_b32 s54, 268435456
  s_mov_b32 s55, 0x20000
  s_barrier
  v_lshl_add_u32 v3, v1, 4, s8
  v_and_b32 v6, 31, v1
  v_lshlrev_b32 v6, 4, v6
  v_lshrrev_b32 v7, 5, v1
  v_mul_u32_u24 v4, 1792, v7
  v_add_u32 v4, v4, v6
  v_mul_u32_u24 v5, 896, v7
  v_add_u32 v5, v5, v6
  s_lshl_b32 s14, s10, 5
  s_lshl_b32 s15, s3, 2
  s_add_u32 s14, s14, s15
  s_mul_i32 s14, s14, 896
  v_add_u32 v4, s14, v4
  s_lshl_b32 s14, s10, 4
  s_lshl_b32 s15, s3, 1
  s_add_u32 s14, s14, s15
  s_mul_i32 s14, s14, 896
  v_add_u32 v5, s14, v5
  v_and_b32 v6, 1, v1
  v_lshlrev_b32 v6, 4, v6
  v_mov_b32 v7, 0xffff
  v_lshlrev_b32 v7, v6, v7
  v_bfe_u32 v6, v1, 1, 2
  v_cmp_eq_u32 s[80:81], 0, v6
  v_cmp_eq_u32 s[82:83], 1, v6
  v_cmp_eq_u32 s[84:85], 2, v6
  v_cmp_eq_u32 s[86:87], 3, v6
  v_cndmask_b32 v8, 0, v7, s[80:81]
  v_cndmask_b32 v9, 0, v7, s[82:83]
  v_cndmask_b32 v10, 0, v7, s[84:85]
  v_cndmask_b32 v11, 0, v7, s[86:87]
  v_lshrrev_b32 v6, 1, v1
  v_xor_b32 v6, v6, v1
  v_bfe_u32 v6, v6, 3, 1
  v_add_u32 v6, -1, v6
  v_and_b32 v8, v8, v6
  v_and_b32 v9, v9, v6
  v_and_b32 v10, v10, v6
  v_and_b32 v11, v11, v6
  s_waitcnt vmcnt(2)
  buffer_load_dwordx4 v[48:51], v2, s[40:43], 0 offen offset:2304 nt
  s_waitcnt vmcnt(2)
  s_mov_b32 s13, 32768
  buffer_load_dwordx4 v[52:55], v2, s[40:43], s13 offen offset:0 nt
  s_waitcnt vmcnt(2)
  buffer_load_dwordx4 v[56:59], v2, s[40:43], s13 offen offset:256 nt
  s_waitcnt vmcnt(2)
  buffer_load_dwordx4 v[60:63], v2, s[40:43], s13 offen offset:2048 nt
  s_waitcnt vmcnt(2)
  buffer_load_dwordx4 v[64:67], v2, s[40:43], s13 offen offset:2304 nt
  s_waitcnt vmcnt(2)
  s_mov_b32 s13, 65536
  buffer_load_dwordx4 v[68:71], v2, s[40:43], s13 offen offset:0 nt
  s_waitcnt vmcnt(2)
  buffer_load_dwordx4 v[72:75], v2, s[40:43], s13 offen offset:256 nt
  s_waitcnt vmcnt(2)
  buffer_load_dwordx4 v[76:79], v2, s[40:43], s13 offen offset:2048 nt
  s_waitcnt vmcnt(2)
  buffer_load_dwordx4 v[80:83], v2, s[40:43], s13 offen offset:2304 nt
  s_waitcnt vmcnt(2)
  s_mov_b32 s13, 98304
  buffer_load_dwordx4 v[84:87], v2, s[40:43], s13 offen offset:0 nt
  s_waitcnt vmcnt(2)
  buffer_load_dwordx4 v[88:91], v2, s[40:43], s13 offen offset:256 nt
  s_waitcnt vmcnt(2)
  buffer_load_dwordx4 v[92:95], v2, s[40:43], s13 offen offset:2048 nt
  s_waitcnt vmcnt(2)
  buffer_load_dwordx4 v[96:99], v2, s[40:43], s13 offen offset:2304 nt
  s_waitcnt vmcnt(2)
  s_mov_b32 s13, 131072
  buffer_load_dwordx4 v[100:103], v2, s[40:43], s13 offen offset:0 nt
  v_mov_b32 v6, 0
  v_mov_b32 v7, 16
  s_mov_b64 exec, 1
  ds_max_u32 v6, v7 offset:27276
  s_mov_b64 exec, -1
  s_waitcnt vmcnt(2)
  buffer_load_dwordx4 v[104:107], v2, s[40:43], s13 offen offset:256 nt
  s_waitcnt vmcnt(2)
  buffer_load_dwordx4 v[108:111], v2, s[40:43], s13 offen offset:2048 nt
  s_waitcnt vmcnt(2)
  buffer_load_dwordx4 v[112:115], v2, s[40:43], s13 offen offset:2304 nt
  s_waitcnt vmcnt(2)
  s_mov_b32 s13, 163840
  buffer_load_dwordx4 v[116:119], v2, s[40:43], s13 offen offset:0 nt
  s_waitcnt vmcnt(2)
  buffer_load_dwordx4 v[120:123], v2, s[40:43], s13 offen offset:256 nt
  s_waitcnt vmcnt(2)
  buffer_load_dwordx4 v[124:127], v2, s[40:43], s13 offen offset:2048 nt
  s_waitcnt vmcnt(2)
  buffer_load_dwordx4 v[128:131], v2, s[40:43], s13 offen offset:2304 nt
  s_waitcnt vmcnt(2)
  s_mov_b32 s13, 196608
  buffer_load_dwordx4 v[132:135], v2, s[40:43], s13 offen offset:0 nt
  s_waitcnt vmcnt(2)
  buffer_load_dwordx4 v[136:139], v2, s[40:43], s13 offen offset:256 nt
  s_waitcnt vmcnt(2)
  v_mov_b32 v6, 0
  s_mov_b32 s80, 4194304
L_wait_q:
  ds_read_b32 v7, v6 offset:27264
  s_waitcnt lgkmcnt(0)
  v_readfirstlane_b32 s81, v7
  s_nop 0
  s_cmp_eq_u32 s81, 1
  s_cbranch_scc1 L_got_q
  s_sleep 1
  s_sub_u32 s80, s80, 1
  s_cmp_lg_u32 s80, 0
  s_cbranch_scc1 L_wait_q
L_got_q:
  v_lshrrev_b32 v6, 4, v1
  v_and_b32 v7, 3, v1
  v_lshl_add_u32 v6, v6, 2, v7
  v_lshlrev_b32 v6, 4, v6
  ds_read_b128 v[12:15], v6 offset:26624
  ds_read_b128 v[16:19], v6 offset:26880
  v_mov_b32 v6, 0
  ds_read_b32 v7, v6 offset:27216
  s_waitcnt lgkmcnt(0)
  v_readfirstlane_b32 s12, v7
  buffer_load_dwordx4 v[140:143], v2, s[40:43], s13 offen offset:2048 nt
  v_mfma_f32_16x16x32_bf16 v[20:23], v[36:39], v[12:15], 0
  v_mfma_f32_16x16x32_bf16 v[20:23], v[40:43], v[16:19], v[20:23]
  v_mfma_f32_16x16x32_bf16 v[24:27], v[44:47], v[12:15], 0
  v_mfma_f32_16x16x32_bf16 v[24:27], v[48:51], v[16:19], v[24:27]
  s_nop 5
  v_mov_b32_dpp v6, v20 quad_perm:[0,0,0,0] row_mask:0xf bank_mask:0xf
  v_add_f32_dpp v6, v21, v6 quad_perm:[1,1,1,1] row_mask:0xf bank_mask:0xf
  v_add_f32_dpp v6, v22, v6 quad_perm:[2,2,2,2] row_mask:0xf bank_mask:0xf
  v_add_f32_dpp v28, v23, v6 quad_perm:[3,3,3,3] row_mask:0xf bank_mask:0x1
  v_mfma_f32_16x16x32_bf16 v[20:23], v[52:55], v[12:15], 0
  v_mfma_f32_16x16x32_bf16 v[20:23], v[56:59], v[16:19], v[20:23]
  v_mov_b32_dpp v6, v24 quad_perm:[0,0,0,0] row_mask:0xf bank_mask:0xf
  v_add_f32_dpp v6, v25, v6 quad_perm:[1,1,1,1] row_mask:0xf bank_mask:0xf
  v_add_f32_dpp v6, v26, v6 quad_perm:[2,2,2,2] row_mask:0xf bank_mask:0xf
  v_add_f32_dpp v28, v27, v6 quad_perm:[3,3,3,3] row_mask:0xf bank_mask:0x2
  s_waitcnt vmcnt(2)
  buffer_load_dwordx4 v[144:147], v2, s[40:43], s13 offen offset:2304 nt
  v_mfma_f32_16x16x32_bf16 v[24:27], v[60:63], v[12:15], 0
  v_mfma_f32_16x16x32_bf16 v[24:27], v[64:67], v[16:19], v[24:27]
  v_mov_b32_dpp v6, v20 quad_perm:[0,0,0,0] row_mask:0xf bank_mask:0xf
  v_add_f32_dpp v6, v21, v6 quad_perm:[1,1,1,1] row_mask:0xf bank_mask:0xf
  v_add_f32_dpp v6, v22, v6 quad_perm:[2,2,2,2] row_mask:0xf bank_mask:0xf
  v_add_f32_dpp v28, v23, v6 quad_perm:[3,3,3,3] row_mask:0xf bank_mask:0x4
  v_mfma_f32_16x16x32_bf16 v[20:23], v[68:71], v[12:15], 0
  v_mfma_f32_16x16x32_bf16 v[20:23], v[72:75], v[16:19], v[20:23]
  s_nop 1
  v_mov_b32_dpp v6, v24 quad_perm:[0,0,0,0] row_mask:0xf bank_mask:0xf
  v_add_f32_dpp v6, v25, v6 quad_perm:[1,1,1,1] row_mask:0xf bank_mask:0xf
  v_add_f32_dpp v6, v26, v6 quad_perm:[2,2,2,2] row_mask:0xf bank_mask:0xf
  v_add_f32_dpp v28, v27, v6 quad_perm:[3,3,3,3] row_mask:0xf bank_mask:0x8
  v_mfma_f32_16x16x32_bf16 v[24:27], v[76:79], v[12:15], 0
  v_mfma_f32_16x16x32_bf16 v[24:27], v[80:83], v[16:19], v[24:27]
  v_mov_b32_dpp v6, v20 quad_perm:[0,0,0,0] row_mask:0xf bank_mask:0xf
  v_add_f32_dpp v6, v21, v6 quad_perm:[1,1,1,1] row_mask:0xf bank_mask:0xf
  v_add_f32_dpp v6, v22, v6 quad_perm:[2,2,2,2] row_mask:0xf bank_mask:0xf
  v_add_f32_dpp v29, v23, v6 quad_perm:[3,3,3,3] row_mask:0xf bank_mask:0x1
  s_waitcnt vmcnt(2)
  s_mov_b32 s13, 229376
  buffer_load_dwordx4 v[148:151], v2, s[40:43], s13 offen offset:0 nt
  v_mfma_f32_16x16x32_bf16 v[20:23], v[84:87], v[12:15], 0
  v_mfma_f32_16x16x32_bf16 v[20:23], v[88:91], v[16:19], v[20:23]
  v_mov_b32_dpp v6, v24 quad_perm:[0,0,0,0] row_mask:0xf bank_mask:0xf
  v_add_f32_dpp v6, v25, v6 quad_perm:[1,1,1,1] row_mask:0xf bank_mask:0xf
  v_add_f32_dpp v6, v26, v6 quad_perm:[2,2,2,2] row_mask:0xf bank_mask:0xf
  v_add_f32_dpp v29, v27, v6 quad_perm:[3,3,3,3] row_mask:0xf bank_mask:0x2
  v_mfma_f32_16x16x32_bf16 v[24:27], v[92:95], v[12:15], 0
  v_mfma_f32_16x16x32_bf16 v[24:27], v[96:99], v[16:19], v[24:27]
  s_nop 1
  v_mov_b32_dpp v6, v20 quad_perm:[0,0,0,0] row_mask:0xf bank_mask:0xf
  v_add_f32_dpp v6, v21, v6 quad_perm:[1,1,1,1] row_mask:0xf bank_mask:0xf
  v_add_f32_dpp v6, v22, v6 quad_perm:[2,2,2,2] row_mask:0xf bank_mask:0xf
  v_add_f32_dpp v29, v23, v6 quad_perm:[3,3,3,3] row_mask:0xf bank_mask:0x4
  v_mfma_f32_16x16x32_bf16 v[20:23], v[100:103], v[12:15], 0
  v_mfma_f32_16x16x32_bf16 v[20:23], v[104:107], v[16:19], v[20:23]
  v_mov_b32_dpp v6, v24 quad_perm:[0,0,0,0] row_mask:0xf bank_mask:0xf
  v_add_f32_dpp v6, v25, v6 quad_perm:[1,1,1,1] row_mask:0xf bank_mask:0xf
  v_add_f32_dpp v6, v26, v6 quad_perm:[2,2,2,2] row_mask:0xf bank_mask:0xf
  v_add_f32_dpp v29, v27, v6 quad_perm:[3,3,3,3] row_mask:0xf bank_mask:0x8
  s_waitcnt vmcnt(2)
  buffer_load_dwordx4 v[152:155], v2, s[40:43], s13 offen offset:256 nt
  v_mfma_f32_16x16x32_bf16 v[24:27], v[108:111], v[12:15], 0
  v_mfma_f32_16x16x32_bf16 v[24:27], v[112:115], v[16:19], v[24:27]
  v_mov_b32_dpp v6, v20 quad_perm:[0,0,0,0] row_mask:0xf bank_mask:0xf
  v_add_f32_dpp v6, v21, v6 quad_perm:[1,1,1,1] row_mask:0xf bank_mask:0xf
  v_add_f32_dpp v6, v22, v6 quad_perm:[2,2,2,2] row_mask:0xf bank_mask:0xf
  v_add_f32_dpp v30, v23, v6 quad_perm:[3,3,3,3] row_mask:0xf bank_mask:0x1
  v_mfma_f32_16x16x32_bf16 v[20:23], v[116:119], v[12:15], 0
  v_mfma_f32_16x16x32_bf16 v[20:23], v[120:123], v[16:19], v[20:23]
  s_nop 1
  v_mov_b32_dpp v6, v24 quad_perm:[0,0,0,0] row_mask:0xf bank_mask:0xf
  v_add_f32_dpp v6, v25, v6 quad_perm:[1,1,1,1] row_mask:0xf bank_mask:0xf
  v_add_f32_dpp v6, v26, v6 quad_perm:[2,2,2,2] row_mask:0xf bank_mask:0xf
  v_add_f32_dpp v30, v27, v6 quad_perm:[3,3,3,3] row_mask:0xf bank_mask:0x2
  v_mfma_f32_16x16x32_bf16 v[24:27], v[124:127], v[12:15], 0
  v_mfma_f32_16x16x32_bf16 v[24:27], v[128:131], v[16:19], v[24:27]
  v_mov_b32_dpp v6, v20 quad_perm:[0,0,0,0] row_mask:0xf bank_mask:0xf
  v_add_f32_dpp v6, v21, v6 quad_perm:[1,1,1,1] row_mask:0xf bank_mask:0xf
  v_add_f32_dpp v6, v22, v6 quad_perm:[2,2,2,2] row_mask:0xf bank_mask:0xf
  v_add_f32_dpp v30, v23, v6 quad_perm:[3,3,3,3] row_mask:0xf bank_mask:0x4
  s_waitcnt vmcnt(2)
  buffer_load_dwordx4 v[156:159], v2, s[40:43], s13 offen offset:2048 nt
  v_mfma_f32_16x16x32_bf16 v[20:23], v[132:135], v[12:15], 0
  v_mfma_f32_16x16x32_bf16 v[20:23], v[136:139], v[16:19], v[20:23]
  v_mov_b32_dpp v6, v24 quad_perm:[0,0,0,0] row_mask:0xf bank_mask:0xf
  v_add_f32_dpp v6, v25, v6 quad_perm:[1,1,1,1] row_mask:0xf bank_mask:0xf
  v_add_f32_dpp v6, v26, v6 quad_perm:[2,2,2,2] row_mask:0xf bank_mask:0xf
  v_add_f32_dpp v30, v27, v6 quad_perm:[3,3,3,3] row_mask:0xf bank_mask:0x8
  v_mfma_f32_16x16x32_bf16 v[24:27], v[140:143], v[12:15], 0
  v_mfma_f32_16x16x32_bf16 v[24:27], v[144:147], v[16:19], v[24:27]
  s_nop 1
  v_mov_b32_dpp v6, v20 quad_perm:[0,0,0,0] row_mask:0xf bank_mask:0xf
  v_add_f32_dpp v6, v21, v6 quad_perm:[1,1,1,1] row_mask:0xf bank_mask:0xf
  v_add_f32_dpp v6, v22, v6 quad_perm:[2,2,2,2] row_mask:0xf bank_mask:0xf
  v_add_f32_dpp v31, v23, v6 quad_perm:[3,3,3,3] row_mask:0xf bank_mask:0x1
  s_waitcnt vmcnt(2)
  buffer_load_dwordx4 v[160:163], v2, s[40:43], s13 offen offset:2304 nt
  s_waitcnt vmcnt(2)
  buffer_load_dwordx4 v[164:167], v3, s[44:47], 0 offen offset:0 nt
  v_mfma_f32_16x16x32_bf16 v[20:23], v[148:151], v[12:15], 0
  v_mfma_f32_16x16x32_bf16 v[20:23], v[152:155], v[16:19], v[20:23]
  v_mov_b32_dpp v6, v24 quad_perm:[0,0,0,0] row_mask:0xf bank_mask:0xf
  v_add_f32_dpp v6, v25, v6 quad_perm:[1,1,1,1] row_mask:0xf bank_mask:0xf
  v_add_f32_dpp v6, v26, v6 quad_perm:[2,2,2,2] row_mask:0xf bank_mask:0xf
  v_add_f32_dpp v31, v27, v6 quad_perm:[3,3,3,3] row_mask:0xf bank_mask:0x2
  s_waitcnt vmcnt(2)
  buffer_load_dwordx4 v[36:39], v3, s[44:47], 0 offen offset:1024 nt
  s_waitcnt vmcnt(2)
  buffer_load_dwordx4 v[40:43], v3, s[44:47], 0 offen offset:2048 nt
  v_mfma_f32_16x16x32_bf16 v[24:27], v[156:159], v[12:15], 0
  v_mfma_f32_16x16x32_bf16 v[24:27], v[160:163], v[16:19], v[24:27]
  v_mov_b32_dpp v6, v20 quad_perm:[0,0,0,0] row_mask:0xf bank_mask:0xf
  v_add_f32_dpp v6, v21, v6 quad_perm:[1,1,1,1] row_mask:0xf bank_mask:0xf
  v_add_f32_dpp v6, v22, v6 quad_perm:[2,2,2,2] row_mask:0xf bank_mask:0xf
  v_add_f32_dpp v31, v23, v6 quad_perm:[3,3,3,3] row_mask:0xf bank_mask:0x4
  s_nop 3
  v_mov_b32_dpp v6, v24 quad_perm:[0,0,0,0] row_mask:0xf bank_mask:0xf
  v_add_f32_dpp v6, v25, v6 quad_perm:[1,1,1,1] row_mask:0xf bank_mask:0xf
  v_add_f32_dpp v6, v26, v6 quad_perm:[2,2,2,2] row_mask:0xf bank_mask:0xf
  v_add_f32_dpp v31, v27, v6 quad_perm:[3,3,3,3] row_mask:0xf bank_mask:0x8
  v_cvt_pk_bf16_f32 v6, v28, v29
  v_cvt_pk_bf16_f32 v7, v30, v31
  v_lshlrev_b32 v28, 16, v6
  v_and_b32 v29, 0xffff0000, v6
  v_lshlrev_b32 v30, 16, v7
  v_and_b32 v31, 0xffff0000, v7
  v_max3_f32 v12, v28, v29, v30
  v_max_f32 v12, v12, v31
  s_nop 1
  v_max_f32_dpp v12, v12, v12 row_ror:4 row_mask:0xf bank_mask:0xf
  s_nop 1
  v_max_f32_dpp v12, v12, v12 row_ror:8 row_mask:0xf bank_mask:0xf
  v_mov_b32 v6, v12
  s_nop 1
  v_permlane16_swap_b32 v12, v6
  v_max_f32 v12, v12, v6
  v_mov_b32 v6, v12
  s_nop 1
  v_permlane32_swap_b32 v12, v6
  v_max_f32 v12, v12, v6
  s_waitcnt vmcnt(2)
  buffer_load_dwordx4 v[44:47], v3, s[44:47], 0 offen offset:3072 nt
  s_mov_b32 s81, 0x3db8aa3b
  v_mul_f32 v12, s81, v12
  v_fma_f32 v13, v28, s81, -v12
  v_fma_f32 v14, v29, s81, -v12
  v_fma_f32 v15, v30, s81, -v12
  v_fma_f32 v16, v31, s81, -v12
  v_exp_f32 v13, v13
  v_exp_f32 v14, v14
  v_exp_f32 v15, v15
  v_exp_f32 v16, v16
  s_lshl_b32 s14, s3, 8
  v_lshl_add_u32 v7, v1, 2, s14
  v_cvt_pk_bf16_f32 v28, v13, v13
  v_cvt_pk_bf16_f32 v29, v14, v14
  v_cvt_pk_bf16_f32 v30, v15, v15
  v_cvt_pk_bf16_f32 v31, v16, v16
  s_mov_b32 exec_lo, 0x11111111
  s_mov_b32 exec_hi, 0x11111111
  ds_write_b128 v7, v[28:31] offset:28672
  s_mov_b64 exec, -1
  v_lshrrev_b32 v7, 5, v1
  v_lshl_add_u32 v7, v7, 6, s14
  ds_read_b128 v[48:51], v7 offset:28672
  ds_read_b128 v[52:55], v7 offset:28800
  ds_read_b128 v[56:59], v7 offset:28688
  ds_read_b128 v[60:63], v7 offset:28816
  ds_read_b128 v[64:67], v7 offset:28704
  ds_read_b128 v[68:71], v7 offset:28832
  ds_read_b128 v[72:75], v7 offset:28720
  ds_read_b128 v[76:79], v7 offset:28848
  v_add_f32 v17, v13, v14
  v_add_f32 v6, v15, v16
  v_add_f32 v17, v17, v6
  s_waitcnt vmcnt(2)
  s_mov_b32 s13, 32768
  buffer_load_dwordx4 v[80:83], v3, s[44:47], s13 offen offset:0 nt
  v_add_f32_dpp v17, v17, v17 row_ror:4 row_mask:0xf bank_mask:0xf
  s_nop 1
  v_add_f32_dpp v17, v17, v17 row_ror:8 row_mask:0xf bank_mask:0xf
  v_mov_b32 v6, v17
  s_nop 1
  v_permlane16_swap_b32 v17, v6
  v_add_f32 v17, v17, v6
  v_mov_b32 v6, v17
  s_nop 1
  v_permlane32_swap_b32 v17, v6
  v_add_f32 v17, v17, v6
  v_mov_b32 v13, v17
  s_lshl_b32 s14, s3, 3
  v_mov_b32 v6, s14
  v_mov_b32 v7, 1
  v_mov_b32 v15, 0
  s_mov_b64 exec, 1
  ds_write_b64 v6, v[12:13] offset:27328
  ds_add_u32 v15, v7 offset:27272
  s_mov_b64 exec, -1
  s_waitcnt lgkmcnt(0)
  s_waitcnt vmcnt(2)
  buffer_load_dwordx4 v[84:87], v3, s[44:47], s13 offen offset:1024 nt
  v_and_b32 v20, v48, v8
  v_and_b32 v21, v48, v9
  v_and_b32 v22, v48, v10
  v_and_b32 v23, v48, v11
  s_nop 1
  v_mfma_f32_16x16x32_bf16 v[32:35], v[20:23], v[164:167], 0
  v_and_b32 v24, v52, v8
  v_and_b32 v25, v52, v9
  v_and_b32 v26, v52, v10
  v_and_b32 v27, v52, v11
  s_nop 1
  v_mfma_f32_16x16x32_bf16 v[32:35], v[24:27], v[36:39], v[32:35]
  v_and_b32 v20, v56, v8
  v_and_b32 v21, v56, v9
  v_and_b32 v22, v56, v10
  v_and_b32 v23, v56, v11
  s_nop 1
  v_mfma_f32_16x16x32_bf16 v[32:35], v[20:23], v[40:43], v[32:35]
  s_waitcnt vmcnt(2)
  buffer_load_dwordx4 v[88:91], v3, s[44:47], s13 offen offset:2048 nt
  v_and_b32 v24, v60, v8
  v_and_b32 v25, v60, v9
  v_and_b32 v26, v60, v10
  v_and_b32 v27, v60, v11
  s_nop 1
  v_mfma_f32_16x16x32_bf16 v[32:35], v[24:27], v[44:47], v[32:35]
  s_waitcnt vmcnt(2)
  buffer_load_dwordx4 v[92:95], v3, s[44:47], s13 offen offset:3072 nt
  v_and_b32 v20, v64, v8
  v_and_b32 v21, v64, v9
  v_and_b32 v22, v64, v10
  v_and_b32 v23, v64, v11
  s_nop 1
  v_mfma_f32_16x16x32_bf16 v[32:35], v[20:23], v[80:83], v[32:35]
  s_waitcnt vmcnt(2)
  s_mov_b32 s13, 65536
  buffer_load_dwordx4 v[96:99], v3, s[44:47], s13 offen offset:0 nt
  v_and_b32 v24, v68, v8
  v_and_b32 v25, v68, v9
  v_and_b32 v26, v68, v10
  v_and_b32 v27, v68, v11
  s_nop 1
  v_mfma_f32_16x16x32_bf16 v[32:35], v[24:27], v[84:87], v[32:35]
  s_waitcnt vmcnt(2)
  buffer_load_dwordx4 v[100:103], v3, s[44:47], s13 offen offset:1024 nt
  v_and_b32 v20, v72, v8
  v_and_b32 v21, v72, v9
  v_and_b32 v22, v72, v10
  v_and_b32 v23, v72, v11
  s_nop 1
  v_mfma_f32_16x16x32_bf16 v[32:35], v[20:23], v[88:91], v[32:35]
  s_waitcnt vmcnt(2)
  buffer_load_dwordx4 v[104:107], v3, s[44:47], s13 offen offset:2048 nt
  v_and_b32 v24, v76, v8
  v_and_b32 v25, v76, v9
  v_and_b32 v26, v76, v10
  v_and_b32 v27, v76, v11
  s_nop 1
  v_mfma_f32_16x16x32_bf16 v[32:35], v[24:27], v[92:95], v[32:35]
  s_waitcnt vmcnt(2)
  buffer_load_dwordx4 v[108:111], v3, s[44:47], s13 offen offset:3072 nt
  v_and_b32 v20, v49, v8
  v_and_b32 v21, v49, v9
  v_and_b32 v22, v49, v10
  v_and_b32 v23, v49, v11
  s_nop 1
  v_mfma_f32_16x16x32_bf16 v[32:35], v[20:23], v[96:99], v[32:35]
  s_waitcnt vmcnt(2)
  s_mov_b32 s13, 98304
  buffer_load_dwordx4 v[112:115], v3, s[44:47], s13 offen offset:0 nt
  v_and_b32 v24, v53, v8
  v_and_b32 v25, v53, v9
  v_and_b32 v26, v53, v10
  v_and_b32 v27, v53, v11
  s_nop 1
  v_mfma_f32_16x16x32_bf16 v[32:35], v[24:27], v[100:103], v[32:35]
  s_waitcnt vmcnt(2)
  buffer_load_dwordx4 v[116:119], v3, s[44:47], s13 offen offset:1024 nt
  v_and_b32 v20, v57, v8
  v_and_b32 v21, v57, v9
  v_and_b32 v22, v57, v10
  v_and_b32 v23, v57, v11
  s_nop 1
  v_mfma_f32_16x16x32_bf16 v[32:35], v[20:23], v[104:107], v[32:35]
  s_waitcnt vmcnt(2)
  buffer_load_dwordx4 v[120:123], v3, s[44:47], s13 offen offset:2048 nt
  v_and_b32 v24, v61, v8
  v_and_b32 v25, v61, v9
  v_and_b32 v26, v61, v10
  v_and_b32 v27, v61, v11
  s_nop 1
  v_mfma_f32_16x16x32_bf16 v[32:35], v[24:27], v[108:111], v[32:35]
  v_mov_b32 v6, 0
  v_mov_b32 v7, 46
  s_mov_b64 exec, 1
  ds_max_u32 v6, v7 offset:27276
  s_mov_b64 exec, -1
  s_waitcnt vmcnt(2)
  buffer_load_dwordx4 v[124:127], v3, s[44:47], s13 offen offset:3072 nt
  v_and_b32 v20, v65, v8
  v_and_b32 v21, v65, v9
  v_and_b32 v22, v65, v10
  v_and_b32 v23, v65, v11
  s_nop 1
  v_mfma_f32_16x16x32_bf16 v[32:35], v[20:23], v[112:115], v[32:35]
  s_waitcnt vmcnt(2)
  s_mov_b32 s13, 131072
  buffer_load_dwordx4 v[128:131], v3, s[44:47], s13 offen offset:0 nt
  v_and_b32 v24, v69, v8
  v_and_b32 v25, v69, v9
  v_and_b32 v26, v69, v10
  v_and_b32 v27, v69, v11
  s_nop 1
  v_mfma_f32_16x16x32_bf16 v[32:35], v[24:27], v[116:119], v[32:35]
  s_waitcnt vmcnt(2)
  buffer_load_dwordx4 v[132:135], v3, s[44:47], s13 offen offset:1024 nt
  v_and_b32 v20, v73, v8
  v_and_b32 v21, v73, v9
  v_and_b32 v22, v73, v10
  v_and_b32 v23, v73, v11
  s_nop 1
  v_mfma_f32_16x16x32_bf16 v[32:35], v[20:23], v[120:123], v[32:35]
  s_waitcnt vmcnt(2)
  buffer_load_dwordx4 v[136:139], v3, s[44:47], s13 offen offset:2048 nt
  v_and_b32 v24, v77, v8
  v_and_b32 v25, v77, v9
  v_and_b32 v26, v77, v10
  v_and_b32 v27, v77, v11
  s_nop 1
  v_mfma_f32_16x16x32_bf16 v[32:35], v[24:27], v[124:127], v[32:35]
  s_waitcnt vmcnt(2)
  buffer_load_dwordx4 v[140:143], v3, s[44:47], s13 offen offset:3072 nt
  v_and_b32 v20, v50, v8
  v_and_b32 v21, v50, v9
  v_and_b32 v22, v50, v10
  v_and_b32 v23, v50, v11
  s_nop 1
  v_mfma_f32_16x16x32_bf16 v[32:35], v[20:23], v[128:131], v[32:35]
  s_waitcnt vmcnt(2)
  s_mov_b32 s13, 163840
  buffer_load_dwordx4 v[144:147], v3, s[44:47], s13 offen offset:0 nt
  v_and_b32 v24, v54, v8
  v_and_b32 v25, v54, v9
  v_and_b32 v26, v54, v10
  v_and_b32 v27, v54, v11
  s_nop 1
  v_mfma_f32_16x16x32_bf16 v[32:35], v[24:27], v[132:135], v[32:35]
  s_waitcnt vmcnt(2)
  buffer_load_dwordx4 v[148:151], v3, s[44:47], s13 offen offset:1024 nt
  v_and_b32 v20, v58, v8
  v_and_b32 v21, v58, v9
  v_and_b32 v22, v58, v10
  v_and_b32 v23, v58, v11
  s_nop 1
  v_mfma_f32_16x16x32_bf16 v[32:35], v[20:23], v[136:139], v[32:35]
  s_waitcnt vmcnt(2)
  buffer_load_dwordx4 v[152:155], v3, s[44:47], s13 offen offset:2048 nt
  v_and_b32 v24, v62, v8
  v_and_b32 v25, v62, v9
  v_and_b32 v26, v62, v10
  v_and_b32 v27, v62, v11
  s_nop 1
  v_mfma_f32_16x16x32_bf16 v[32:35], v[24:27], v[140:143], v[32:35]
  s_waitcnt vmcnt(2)
  buffer_load_dwordx4 v[156:159], v3, s[44:47], s13 offen offset:3072 nt
  v_and_b32 v20, v66, v8
  v_and_b32 v21, v66, v9
  v_and_b32 v22, v66, v10
  v_and_b32 v23, v66, v11
  s_nop 1
  v_mfma_f32_16x16x32_bf16 v[32:35], v[20:23], v[144:147], v[32:35]
  s_waitcnt vmcnt(2)
  s_mov_b32 s13, 196608
  buffer_load_dwordx4 v[160:163], v3, s[44:47], s13 offen offset:0 nt
  v_and_b32 v24, v70, v8
  v_and_b32 v25, v70, v9
  v_and_b32 v26, v70, v10
  v_and_b32 v27, v70, v11
  s_nop 1
  v_mfma_f32_16x16x32_bf16 v[32:35], v[24:27], v[148:151], v[32:35]
  s_waitcnt vmcnt(2)
  buffer_load_dwordx4 v[164:167], v3, s[44:47], s13 offen offset:1024 nt
  v_and_b32 v20, v74, v8
  v_and_b32 v21, v74, v9
  v_and_b32 v22, v74, v10
  v_and_b32 v23, v74, v11
  s_nop 1
  v_mfma_f32_16x16x32_bf16 v[32:35], v[20:23], v[152:155], v[32:35]
  s_waitcnt vmcnt(2)
  buffer_load_dwordx4 v[36:39], v3, s[44:47], s13 offen offset:2048 nt
  v_and_b32 v24, v78, v8
  v_and_b32 v25, v78, v9
  v_and_b32 v26, v78, v10
  v_and_b32 v27, v78, v11
  s_nop 1
  v_mfma_f32_16x16x32_bf16 v[32:35], v[24:27], v[156:159], v[32:35]
  s_waitcnt vmcnt(2)
  buffer_load_dwordx4 v[40:43], v3, s[44:47], s13 offen offset:3072 nt
  v_and_b32 v20, v51, v8
  v_and_b32 v21, v51, v9
  v_and_b32 v22, v51, v10
  v_and_b32 v23, v51, v11
  s_nop 1
  v_mfma_f32_16x16x32_bf16 v[32:35], v[20:23], v[160:163], v[32:35]
  s_waitcnt vmcnt(2)
  s_mov_b32 s13, 229376
  buffer_load_dwordx4 v[44:47], v3, s[44:47], s13 offen offset:0 nt
  v_and_b32 v24, v55, v8
  v_and_b32 v25, v55, v9
  v_and_b32 v26, v55, v10
  v_and_b32 v27, v55, v11
  s_nop 1
  v_mfma_f32_16x16x32_bf16 v[32:35], v[24:27], v[164:167], v[32:35]
  s_waitcnt vmcnt(2)
  buffer_load_dwordx4 v[80:83], v3, s[44:47], s13 offen offset:1024 nt
  v_and_b32 v20, v59, v8
  v_and_b32 v21, v59, v9
  v_and_b32 v22, v59, v10
  v_and_b32 v23, v59, v11
  s_nop 1
  v_mfma_f32_16x16x32_bf16 v[32:35], v[20:23], v[36:39], v[32:35]
  s_waitcnt vmcnt(2)
  buffer_load_dwordx4 v[84:87], v3, s[44:47], s13 offen offset:2048 nt
  v_and_b32 v24, v63, v8
  v_and_b32 v25, v63, v9
  v_and_b32 v26, v63, v10
  v_and_b32 v27, v63, v11
  s_nop 1
  v_mfma_f32_16x16x32_bf16 v[32:35], v[24:27], v[40:43], v[32:35]
  v_mov_b32 v6, 0
  s_mov_b32 s80, 4194304
L_wait_st:
  ds_read_b32 v7, v6 offset:27268
  s_waitcnt lgkmcnt(0)
  v_readfirstlane_b32 s81, v7
  s_nop 0
  s_cmp_eq_u32 s81, 1
  s_cbranch_scc1 L_got_st
  s_sleep 1
  s_sub_u32 s80, s80, 1
  s_cmp_lg_u32 s80, 0
  s_cbranch_scc1 L_wait_st
L_got_st:
  ds_read_b128 v[14:17], v6 offset:27200
  v_lshrrev_b32 v7, 5, v1
  s_lshl_b32 s14, s3, 3
  v_lshl_add_u32 v7, v7, 2, s14
  ds_read_b32 v19, v7 offset:27136
  s_waitcnt lgkmcnt(0)
  v_readfirstlane_b32 s78, v14
  v_add_f32 v18, v12, v16
  v_exp_f32 v18, v18
  s_nop 0
  v_mul_f32 v18, v18, v17
  s_waitcnt vmcnt(2)
  buffer_load_dwordx4 v[88:91], v3, s[44:47], s13 offen offset:3072 nt
  v_and_b32 v20, v67, v8
  v_and_b32 v21, v67, v9
  v_and_b32 v22, v67, v10
  v_and_b32 v23, v67, v11
  s_nop 1
  v_mfma_f32_16x16x32_bf16 v[32:35], v[20:23], v[44:47], v[32:35]
  v_and_b32 v6, 15, v1
  v_lshlrev_b32 v2, 5, v6
  v_lshrrev_b32 v6, 5, v1
  v_lshl_add_u32 v2, v6, 9, v2
  v_bfe_u32 v6, v1, 4, 1
  v_lshl_add_u32 v2, v6, 4, v2
  s_lshl_b32 s14, s3, 10
  v_add_u32 v16, s14, v2
  s_lshl_b32 s14, s3, 11
  s_add_u32 s14, s14, 32768
  v_add_u32 v2, s14, v2
  s_lshl_b32 s14, s3, 6
  v_add_u32 v13, s14, v1
  v_lshrrev_b32 v6, 4, v13
  v_lshlrev_b32 v3, 11, v6
  v_and_b32 v6, 15, v1
  v_lshl_add_u32 v3, v6, 4, v3
  s_lshl_b32 s9, s7, 14
  s_add_u32 s9, s9, 524288
  s_lshl_b32 s14, s6, 8
  s_add_u32 s11, s9, s14
  s_waitcnt vmcnt(2)
  v_and_b32 v24, v71, v8
  v_and_b32 v25, v71, v9
  v_and_b32 v26, v71, v10
  v_and_b32 v27, v71, v11
  s_nop 1
  v_mfma_f32_16x16x32_bf16 v[32:35], v[24:27], v[80:83], v[32:35]
  s_waitcnt vmcnt(1)
  v_and_b32 v20, v75, v8
  v_and_b32 v21, v75, v9
  v_and_b32 v22, v75, v10
  v_and_b32 v23, v75, v11
  s_nop 1
  v_mfma_f32_16x16x32_bf16 v[32:35], v[20:23], v[84:87], v[32:35]
  s_waitcnt vmcnt(0)
  buffer_load_dwordx4 v[92:95], v5, s[64:67], 0 offen offset:0 nt
  buffer_load_dwordx4 v[96:99], v5, s[64:67], 0 offen offset:512 nt
  buffer_load_dwordx4 v[100:103], v4, s[48:51], 0 offen offset:0 nt
  buffer_load_dwordx4 v[104:107], v4, s[48:51], 0 offen offset:512 nt
  buffer_load_dwordx4 v[108:111], v4, s[48:51], 0 offen offset:896 nt
  buffer_load_dwordx4 v[112:115], v4, s[48:51], 0 offen offset:1408 nt
  v_and_b32 v24, v79, v8
  v_and_b32 v25, v79, v9
  v_and_b32 v26, v79, v10
  v_and_b32 v27, v79, v11
  s_nop 1
  v_mfma_f32_16x16x32_bf16 v[32:35], v[24:27], v[88:91], v[32:35]
L_tail:
  v_lshlrev_b32 v6, 3, v13
  s_nop 6
  v_mul_f32 v32, v18, v32
  v_mul_f32 v33, v18, v33
  v_mul_f32 v34, v18, v34
  v_mul_f32 v35, v18, v35
  ds_write_b128 v16, v[32:35] offset:0
  s_waitcnt lgkmcnt(0)
  s_barrier
  s_cmp_ge_u32 s3, 2
  s_cbranch_scc1 L_odone
  ds_read_b64 v[36:37], v6 offset:0
  ds_read_b64 v[38:39], v6 offset:1024
  ds_read_b64 v[40:41], v6 offset:2048
  ds_read_b64 v[42:43], v6 offset:3072
  ds_read_b64 v[44:45], v6 offset:4096
  ds_read_b64 v[46:47], v6 offset:5120
  ds_read_b64 v[48:49], v6 offset:6144
  ds_read_b64 v[50:51], v6 offset:7168
  v_mov_b32 v21, s12
  v_mov_b32 v23, s12
  s_waitcnt lgkmcnt(0)
  v_add_f32 v36, v36, v38
  v_add_f32 v37, v37, v39
  v_add_f32 v40, v40, v42
  v_add_f32 v41, v41, v43
  v_add_f32 v44, v44, v46
  v_add_f32 v45, v45, v47
  v_add_f32 v48, v48, v50
  v_add_f32 v49, v49, v51
  v_add_f32 v36, v36, v40
  v_add_f32 v37, v37, v41
  v_add_f32 v44, v44, v48
  v_add_f32 v45, v45, v49
  v_add_f32 v20, v36, v44
  v_add_f32 v22, v37, v45
  s_cmp_eq_u32 s78, 1
  s_cbranch_scc1 L_xl1
  buffer_store_dwordx4 v[20:23], v3, s[52:55], s11 offen sc1
  s_branch L_xd1
L_xl1:
  buffer_store_dwordx4 v[20:23], v3, s[52:55], s11 offen
L_xd1:
L_odone:
  v_and_b32 v32, v19, v8
  v_and_b32 v33, v19, v9
  v_and_b32 v34, v19, v10
  v_and_b32 v35, v19, v11
  v_add_u32 v6, 32768, v6
  v_lshrrev_b32 v7, 5, v1
  s_lshl_b32 s14, s3, 4
  v_lshl_add_u32 v7, v7, 3, s14
  s_waitcnt vmcnt(4)
  v_mfma_f32_16x16x32_bf16 v[36:39], v[32:35], v[92:95], 0
  v_mfma_f32_16x16x32_bf16 v[40:43], v[32:35], v[96:99], 0
  s_nop 6
  v_mul_f32 v36, v15, v36
  v_mul_f32 v37, v15, v37
  v_mul_f32 v38, v15, v38
  v_mul_f32 v39, v15, v39
  v_mul_f32 v40, v15, v40
  v_mul_f32 v41, v15, v41
  v_mul_f32 v42, v15, v42
  v_mul_f32 v43, v15, v43
  v_and_b32 v7, 7, v1
  v_lshlrev_b32 v3, 8, v7
  v_lshrrev_b32 v7, 5, v1
  v_lshl_add_u32 v3, v7, 4, v3
  s_lshl_b32 s9, s7, 14
  s_add_u32 s9, s9, 524288
  s_lshl_b32 s14, s6, 11
  s_add_u32 s9, s9, s14
  s_lshl_b32 s14, s3, 5
  s_add_u32 s9, s9, s14
  s_mov_b32 s82, -1
  s_mov_b32 s83, -1
  s_mov_b32 s80, 524288
L_g_od:
  s_mov_b64 exec, s[82:83]
  buffer_load_dwordx4 v[28:31], v3, s[52:55], s9 offen offset:0 sc1
  s_waitcnt vmcnt(0)
  v_cmp_ne_u32 vcc, s12, v29
  v_cmp_ne_u32 s[82:83], s12, v31
  s_nop 0
  s_or_b64 s[82:83], s[82:83], vcc
  s_mov_b64 s[14:15], s[82:83]
  s_cmp_eq_u64 s[14:15], 0
  s_cbranch_scc1 L_g_od_ok
  s_sub_u32 s80, s80, 1
  s_cmp_lg_u32 s80, 0
  s_cbranch_scc1 L_g_od
L_g_od_ok:
  s_mov_b64 exec, -1
  v_add_f32_dpp v28, v28, v28 quad_perm:[1,0,3,2] row_mask:0xf bank_mask:0xf
  v_add_f32_dpp v30, v30, v30 quad_perm:[1,0,3,2] row_mask:0xf bank_mask:0xf
  s_nop 0
  v_add_f32_dpp v28, v28, v28 quad_perm:[2,3,0,1] row_mask:0xf bank_mask:0xf
  v_add_f32_dpp v30, v30, v30 quad_perm:[2,3,0,1] row_mask:0xf bank_mask:0xf
  s_nop 0
  v_add_f32_dpp v28, v28, v28 row_half_mirror row_mask:0xf bank_mask:0xf
  v_add_f32_dpp v30, v30, v30 row_half_mirror row_mask:0xf bank_mask:0xf
  v_cvt_pk_bf16_f32 v28, v28, v28
  v_cvt_pk_bf16_f32 v29, v30, v30
  v_and_b32 v20, v28, v8
  v_and_b32 v21, v28, v9
  v_and_b32 v22, v28, v10
  v_and_b32 v23, v28, v11
  v_and_b32 v24, v29, v8
  v_and_b32 v25, v29, v9
  v_and_b32 v26, v29, v10
  v_and_b32 v27, v29, v11
  v_mfma_f32_16x16x32_bf16 v[36:39], v[20:23], v[100:103], v[36:39]
  v_mfma_f32_16x16x32_bf16 v[40:43], v[20:23], v[104:107], v[40:43]
  v_mfma_f32_16x16x32_bf16 v[36:39], v[24:27], v[108:111], v[36:39]
  v_mfma_f32_16x16x32_bf16 v[40:43], v[24:27], v[112:115], v[40:43]
  s_nop 6
  ds_write_b128 v2, v[36:39]
  ds_write_b128 v2, v[40:43] offset:1024
  s_waitcnt lgkmcnt(0)
  s_barrier
  s_cmp_ge_u32 s3, 4
  s_cbranch_scc1 L_ydone
  ds_read_b64 v[36:37], v6 offset:0
  ds_read_b64 v[38:39], v6 offset:2048
  ds_read_b64 v[40:41], v6 offset:4096
  ds_read_b64 v[42:43], v6 offset:6144
  ds_read_b64 v[44:45], v6 offset:8192
  ds_read_b64 v[46:47], v6 offset:10240
  ds_read_b64 v[48:49], v6 offset:12288
  ds_read_b64 v[50:51], v6 offset:14336
  v_cmp_gt_u32 vcc, 224, v13
  v_lshrrev_b32 v7, 3, v13
  v_lshlrev_b32 v3, 14, v7
  v_and_b32 v7, 7, v1
  v_lshl_add_u32 v3, v7, 4, v3
  s_mul_i32 s14, s4, 458752
  s_lshl_b32 s15, s10, 7
  s_add_u32 s14, s14, s15
  s_add_u32 s14, s14, 1048576
  v_mov_b32 v21, s12
  v_mov_b32 v23, s12
  s_waitcnt lgkmcnt(0)
  v_add_f32 v36, v36, v38
  v_add_f32 v37, v37, v39
  v_add_f32 v40, v40, v42
  v_add_f32 v41, v41, v43
  v_add_f32 v44, v44, v46
  v_add_f32 v45, v45, v47
  v_add_f32 v48, v48, v50
  v_add_f32 v49, v49, v51
  v_add_f32 v36, v36, v40
  v_add_f32 v37, v37, v41
  v_add_f32 v44, v44, v48
  v_add_f32 v45, v45, v49
  v_add_f32 v20, v36, v44
  v_add_f32 v22, v37, v45
  s_and_saveexec_b64 s[82:83], vcc
  buffer_store_dwordx4 v[20:23], v3, s[52:55], s14 offen sc1
  s_mov_b64 exec, s[82:83]
L_ydone:
  s_cmp_ge_u32 s2, 56
  s_cbranch_scc1 L_fin_skip
  s_mov_b32 s76, s34
  s_mov_b32 s77, s35
  s_mov_b32 s78, 1792
  s_mov_b32 s79, 0x20000
  s_lshl_b32 s13, s2, 14
  s_lshl_b32 s15, s3, 11
  s_add_u32 s13, s13, s15
  s_add_u32 s13, s13, 1048576
  v_lshlrev_b32 v6, 4, v1
  s_mov_b32 s82, -1
  s_mov_b32 s83, -1
  s_mov_b32 s84, -1
  s_mov_b32 s85, -1
  s_mov_b32 s80, 524288
L_g_fin:
  s_mov_b64 exec, s[82:83]
  s_cbranch_execz L_g_fin_s0
  buffer_load_dwordx4 v[24:27], v6, s[52:55], s13 offen offset:0 sc1
L_g_fin_s0:
  s_mov_b64 exec, s[84:85]
  s_cbranch_execz L_g_fin_s1
  buffer_load_dwordx4 v[28:31], v6, s[52:55], s13 offen offset:1024 sc1
L_g_fin_s1:
  s_waitcnt vmcnt(0)
  s_mov_b64 exec, s[82:83]
  v_cmp_ne_u32 vcc, s12, v25
  v_cmp_ne_u32 s[82:83], s12, v27
  s_nop 0
  s_or_b64 s[82:83], s[82:83], vcc
  s_mov_b64 s[14:15], s[82:83]
  s_mov_b64 exec, s[84:85]
  v_cmp_ne_u32 vcc, s12, v29
  v_cmp_ne_u32 s[84:85], s12, v31
  s_nop 0
  s_or_b64 s[84:85], s[84:85], vcc
  s_or_b64 s[14:15], s[14:15], s[84:85]
  s_cmp_eq_u64 s[14:15], 0
  s_cbranch_scc1 L_g_fin_ok
  s_sub_u32 s80, s80, 1
  s_cmp_lg_u32 s80, 0
  s_cbranch_scc1 L_g_fin
L_g_fin_ok:
  s_mov_b64 exec, -1
  v_add_f32 v24, v24, v28
  v_add_f32 v26, v26, v30
  s_nop 0
  v_add_f32_dpp v24, v24, v24 row_ror:8 row_mask:0xf bank_mask:0xf
  v_add_f32_dpp v26, v26, v26 row_ror:8 row_mask:0xf bank_mask:0xf
  s_nop 1
  v_permlane16_swap_b32 v24, v26
  v_add_f32 v24, v24, v26
  v_mov_b32 v26, v24
  s_nop 1
  v_permlane32_swap_b32 v24, v26
  v_add_f32 v24, v24, v26
  v_and_b32 v6, 7, v1
  v_bfe_u32 v7, v1, 4, 1
  v_lshl_add_u32 v6, v6, 1, v7
  v_lshlrev_b32 v6, 5, v6
  s_lshl_b32 s14, s3, 2
  v_add_u32 v6, s14, v6
  s_mov_b32 exec_lo, 0x00ff00ff
  s_mov_b32 exec_hi, 0
  ds_write_b32 v6, v24 offset:27648
  s_mov_b64 exec, -1
  s_waitcnt lgkmcnt(0)
  s_barrier
  s_cmp_lg_u32 s3, 0
  s_cbranch_scc1 L_fin_skip
  v_and_b32 v6, 15, v1
  v_lshlrev_b32 v7, 5, v6
  ds_read_b128 v[24:27], v7 offset:27648
  ds_read_b128 v[28:31], v7 offset:27664
  v_lshlrev_b32 v6, 1, v6
  s_lshl_b32 s14, s2, 5
  s_waitcnt lgkmcnt(0)
  v_add_f32 v24, v24, v25
  v_add_f32 v26, v26, v27
  v_add_f32 v28, v28, v29
  v_add_f32 v30, v30, v31
  v_add_f32 v24, v24, v26
  v_add_f32 v28, v28, v30
  v_add_f32 v24, v24, v28
  v_cvt_pk_bf16_f32 v24, v24, v24
  s_mov_b64 exec, 0xffff
  buffer_store_short v24, v6, s[76:79], s14 offen
  s_cmp_lg_u32 s2, 0
  s_cbranch_scc1 L_fin_noep
  s_mov_b64 exec, 1
  v_mov_b32 v6, 0
  v_mov_b32 v7, s12
  s_mov_b32 s13, 0
  buffer_store_dword v7, v6, s[52:55], s13 offen
L_fin_noep:
  s_mov_b64 exec, -1
L_fin_skip:
  s_endpgm
L_service:
  s_setprio 3
  v_mov_b32 v14, 0
  v_mov_b32 v15, 0
  v_mov_b32 v16, 0
  v_mov_b32 v17, 0
  ds_write_b128 v14, v[14:17] offset:27264
  v_lshlrev_b32 v2, 4, v1
  s_and_b32 s8, s6, 3
  s_lshr_b32 s9, s6, 2
  s_lshl_b32 s14, s4, 1
  s_add_u32 s9, s9, s14
  s_lshl_b32 s15, s4, 3
  s_add_u32 s15, s15, s6
  s_cmp_ge_u32 s15, 7
  s_cselect_b32 s11, 1, 0
  s_mul_i32 s14, s11, 7
  s_sub_u32 s81, s15, s14
  s_cmp_lt_u32 s15, 14
  s_cselect_b32 s79, 1, 0
  s_cmp_lt_u32 s5, 14
  s_cselect_b32 s79, s79, 0
  s_lshl_b32 s14, s5, 1
  s_add_u32 s11, s11, s14
  v_bfe_u32 v14, v1, 4, 1
  v_lshlrev_b32 v14, 1, v14
  v_and_b32 v15, 7, v1
  v_xor_b32 v14, v14, v15
  v_xor_b32 v15, 4, v14
  v_lshrrev_b32 v16, 3, v1
  s_mul_i32 s14, s9, 917504
  s_lshl_b32 s15, s5, 9
  s_add_u32 s14, s14, s15
  s_lshl_b32 s15, s8, 7
  s_add_u32 s14, s14, s15
  v_lshl_add_u32 v17, v16, 13, s14
  v_lshl_add_u32 v3, v14, 4, v17
  v_lshl_add_u32 v4, v15, 4, v17
  s_mul_i32 s14, s81, 229376
  s_lshl_b32 s15, s11, 7
  s_add_u32 s14, s14, s15
  v_mul_u32_u24 v17, 3584, v16
  v_add_u32 v17, s14, v17
  v_lshl_add_u32 v5, v14, 4, v17
  v_lshl_add_u32 v6, v15, 4, v17
  s_waitcnt lgkmcnt(0)
  s_mov_b32 s13, 0
  s_load_dword s12, s[38:39], s13
  s_mov_b32 s68, s16
  s_mov_b32 s69, s17
  s_mov_b32 s70, 1792
  s_mov_b32 s71, 0x20000
  s_mov_b32 s56, s22
  s_mov_b32 s57, s23
  s_mov_b32 s58, 3670016
  s_mov_b32 s59, 0x20000
  s_mov_b32 s72, s32
  s_mov_b32 s73, s33
  s_mov_b32 s74, 896
  s_mov_b32 s75, 0x20000
  s_mov_b32 s60, s28
  s_mov_b32 s61, s29
  s_mov_b32 s62, 1605632
  s_mov_b32 s63, 0x20000
  s_cmp_eq_u32 s79, 1
  s_cselect_b32 s62, s62, 0
  s_mov_b32 m0, 24576
  s_nop 0
  buffer_load_dwordx4 v2, s[68:71], 0 offen offset:0 lds
  buffer_load_dwordx4 v2, s[68:71], 0 offen offset:1024 lds
  s_mov_b32 m0, 0
  s_mov_b32 s13, 0
  buffer_load_dwordx4 v3, s[56:59], s13 offen nt lds
  s_mov_b32 m0, 1024
  s_mov_b32 s13, 65536
  buffer_load_dwordx4 v4, s[56:59], s13 offen nt lds
  s_mov_b32 m0, 2048
  s_mov_b32 s13, 131072
  buffer_load_dwordx4 v3, s[56:59], s13 offen nt lds
  s_mov_b32 m0, 3072
  s_mov_b32 s13, 196608
  buffer_load_dwordx4 v4, s[56:59], s13 offen nt lds
  s_mov_b32 m0, 4096
  s_mov_b32 s13, 262144
  buffer_load_dwordx4 v3, s[56:59], s13 offen nt lds
  s_mov_b32 m0, 5120
  s_mov_b32 s13, 327680
  buffer_load_dwordx4 v4, s[56:59], s13 offen nt lds
  s_mov_b32 m0, 6144
  s_mov_b32 s13, 393216
  buffer_load_dwordx4 v3, s[56:59], s13 offen nt lds
  s_mov_b32 m0, 7168
  s_mov_b32 s13, 458752
  buffer_load_dwordx4 v4, s[56:59], s13 offen nt lds
  s_mov_b32 m0, 8192
  s_mov_b32 s13, 524288
  buffer_load_dwordx4 v3, s[56:59], s13 offen nt lds
  s_mov_b32 m0, 9216
  s_mov_b32 s13, 589824
  buffer_load_dwordx4 v4, s[56:59], s13 offen nt lds
  s_mov_b32 m0, 10240
  s_mov_b32 s13, 655360
  buffer_load_dwordx4 v3, s[56:59], s13 offen nt lds
  s_mov_b32 m0, 11264
  s_mov_b32 s13, 720896
  buffer_load_dwordx4 v4, s[56:59], s13 offen nt lds
  s_mov_b32 m0, 12288
  s_mov_b32 s13, 786432
  buffer_load_dwordx4 v3, s[56:59], s13 offen nt lds
  s_mov_b32 m0, 13312
  s_mov_b32 s13, 851968
  buffer_load_dwordx4 v4, s[56:59], s13 offen nt lds
  s_mov_b32 m0, 14336
  s_mov_b32 s13, 2130706432
  buffer_load_dwordx4 v3, s[56:59], s13 offen nt lds
  s_mov_b32 m0, 15360
  s_mov_b32 s13, 2130706432
  buffer_load_dwordx4 v4, s[56:59], s13 offen nt lds
  s_mov_b32 m0, 16384
  s_mov_b32 s13, 0
  buffer_load_dwordx4 v5, s[60:63], s13 offen nt lds
  s_mov_b32 m0, 17408
  s_mov_b32 s13, 28672
  buffer_load_dwordx4 v6, s[60:63], s13 offen nt lds
  s_mov_b32 m0, 18432
  s_mov_b32 s13, 57344
  buffer_load_dwordx4 v5, s[60:63], s13 offen nt lds
  s_mov_b32 m0, 19456
  s_mov_b32 s13, 86016
  buffer_load_dwordx4 v6, s[60:63], s13 offen nt lds
  s_mov_b32 m0, 20480
  s_mov_b32 s13, 114688
  buffer_load_dwordx4 v5, s[60:63], s13 offen nt lds
  s_mov_b32 m0, 21504
  s_mov_b32 s13, 143360
  buffer_load_dwordx4 v6, s[60:63], s13 offen nt lds
  s_mov_b32 m0, 22528
  s_mov_b32 s13, 172032
  buffer_load_dwordx4 v5, s[60:63], s13 offen nt lds
  s_mov_b32 m0, 23552
  s_mov_b32 s13, 200704
  buffer_load_dwordx4 v6, s[60:63], s13 offen nt lds
  buffer_load_dwordx4 v[24:27], v2, s[72:75], 0 offen
  s_barrier
  s_mov_b32 s52, s38
  s_mov_b32 s53, s39
  s_mov_b32 s54, 268435456
  s_mov_b32 s55, 0x20000
  v_and_b32 v14, 1, v1
  v_mul_u32_u24 v15, 896, v14
  v_lshrrev_b32 v14, 4, v1
  v_lshl_add_u32 v15, v14, 4, v15
  s_mul_i32 s14, s9, 224
  v_add_u32 v7, s14, v15
  s_lshl_b32 s14, s81, 7
  v_add_u32 v8, s14, v15
  v_lshlrev_b32 v15, 10, v14
  v_bfe_u32 v16, v1, 2, 2
  v_lshl_add_u32 v15, v16, 7, v15
  v_bfe_u32 v16, v1, 1, 1
  v_lshl_add_u32 v15, v16, 4, v15
  v_and_b32 v16, 1, v1
  v_lshl_add_u32 v15, v16, 3, v15
  v_bfe_u32 v16, v1, 3, 2
  v_xor_b32 v17, 0, v16
  v_lshl_add_u32 v9, v17, 5, v15
  v_xor_b32 v17, 1, v16
  v_lshl_add_u32 v10, v17, 5, v15
  v_xor_b32 v17, 2, v16
  v_lshl_add_u32 v11, v17, 5, v15
  v_xor_b32 v17, 3, v16
  v_lshl_add_u32 v12, v17, 5, v15
  s_lshl_b32 s8, s8, 9
  s_lshl_b32 s9, s9, 11
  s_add_u32 s8, s8, s9
  s_lshl_b32 s9, s5, 13
  s_add_u32 s8, s8, s9
  s_add_u32 s8, s8, 262144
  s_add_u32 s9, s8, 131072
  s_mul_i32 s11, s11, 4096
  s_lshl_b32 s81, s81, 9
  s_add_u32 s11, s11, s81
  s_add_u32 s11, s11, 32768
  s_mov_b32 s82, 0xffff0000
  s_mov_b32 s83, 0
  s_mov_b32 s84, 0
  s_mov_b32 s85, 0xffff
  s_mov_b32 s86, 0
  s_mov_b32 s87, 0xffff0000
  s_waitcnt lgkmcnt(0)
  s_add_u32 s12, s12, 2654435769
  s_getreg_b32 s78, hwreg(HW_REG_XCC_ID)
  s_and_b32 s78, s78, 15
  v_mov_b32 v152, s78
  v_mov_b32 v153, s12
  v_mov_b32 v154, s78
  v_mov_b32 v155, s12
  s_lshl_b32 s13, s10, 7
  s_lshl_b32 s14, s4, 14
  s_add_u32 s13, s13, s14
  s_add_u32 s13, s13, 2064384
  s_mov_b64 exec, 0xff
  buffer_store_dwordx4 v[152:155], v2, s[52:55], s13 offen
  s_mov_b64 exec, -1
  s_waitcnt vmcnt(26)
  ds_read_b128 v[28:31], v7 offset:24576
  ds_read_b128 v[32:35], v7 offset:24640
  ds_read_b128 v[36:39], v7 offset:24704
  ds_read_b128 v[40:43], v7 offset:24768
  ds_read_b128 v[44:47], v8 offset:24576
  ds_read_b128 v[48:51], v8 offset:24640
  v_lshlrev_b32 v17, 3, v1
  s_waitcnt vmcnt(22)
  ds_read_b64_tr_b16 v[56:57], v9 offset:0
  ds_read_b64_tr_b16 v[58:59], v9 offset:512
  ds_read_b64_tr_b16 v[60:61], v10 offset:0
  ds_read_b64_tr_b16 v[62:63], v10 offset:512
  ds_read_b64_tr_b16 v[64:65], v11 offset:0
  ds_read_b64_tr_b16 v[66:67], v11 offset:512
  ds_read_b64_tr_b16 v[68:69], v12 offset:0
  ds_read_b64_tr_b16 v[70:71], v12 offset:512
  s_waitcnt vmcnt(18)
  ds_read_b64_tr_b16 v[72:73], v9 offset:4096
  ds_read_b64_tr_b16 v[74:75], v9 offset:4608
  ds_read_b64_tr_b16 v[76:77], v10 offset:4096
  ds_read_b64_tr_b16 v[78:79], v10 offset:4608
  ds_read_b64_tr_b16 v[80:81], v11 offset:4096
  ds_read_b64_tr_b16 v[82:83], v11 offset:4608
  ds_read_b64_tr_b16 v[84:85], v12 offset:4096
  ds_read_b64_tr_b16 v[86:87], v12 offset:4608
  s_waitcnt lgkmcnt(8)
  v_mfma_f32_16x16x32_bf16 v[120:123], v[28:31], v[56:59], 0
  v_mfma_f32_16x16x32_bf16 v[124:127], v[28:31], v[60:63], 0
  v_mfma_f32_16x16x32_bf16 v[128:131], v[28:31], v[64:67], 0
  v_mfma_f32_16x16x32_bf16 v[132:135], v[28:31], v[68:71], 0
  s_waitcnt vmcnt(14)
  ds_read_b64_tr_b16 v[88:89], v9 offset:8192
  ds_read_b64_tr_b16 v[90:91], v9 offset:8704
  ds_read_b64_tr_b16 v[92:93], v10 offset:8192
  ds_read_b64_tr_b16 v[94:95], v10 offset:8704
  ds_read_b64_tr_b16 v[96:97], v11 offset:8192
  ds_read_b64_tr_b16 v[98:99], v11 offset:8704
  ds_read_b64_tr_b16 v[100:101], v12 offset:8192
  ds_read_b64_tr_b16 v[102:103], v12 offset:8704
  s_waitcnt lgkmcnt(8)
  v_mfma_f32_16x16x32_bf16 v[120:123], v[32:35], v[72:75], v[120:123]
  v_mfma_f32_16x16x32_bf16 v[124:127], v[32:35], v[76:79], v[124:127]
  v_mfma_f32_16x16x32_bf16 v[128:131], v[32:35], v[80:83], v[128:131]
  v_mfma_f32_16x16x32_bf16 v[132:135], v[32:35], v[84:87], v[132:135]
  s_waitcnt vmcnt(10)
  ds_read_b64_tr_b16 v[104:105], v9 offset:12288
  ds_read_b64_tr_b16 v[106:107], v9 offset:12800
  ds_read_b64_tr_b16 v[108:109], v10 offset:12288
  ds_read_b64_tr_b16 v[110:111], v10 offset:12800
  ds_read_b64_tr_b16 v[112:113], v11 offset:12288
  ds_read_b64_tr_b16 v[114:115], v11 offset:12800
  ds_read_b64_tr_b16 v[116:117], v12 offset:12288
  ds_read_b64_tr_b16 v[118:119], v12 offset:12800
  s_waitcnt lgkmcnt(8)
  v_mfma_f32_16x16x32_bf16 v[120:123], v[36:39], v[88:91], v[120:123]
  v_mfma_f32_16x16x32_bf16 v[124:127], v[36:39], v[92:95], v[124:127]
  v_mfma_f32_16x16x32_bf16 v[128:131], v[36:39], v[96:99], v[128:131]
  v_mfma_f32_16x16x32_bf16 v[132:135], v[36:39], v[100:103], v[132:135]
  s_waitcnt lgkmcnt(0)
  v_mfma_f32_16x16x32_bf16 v[120:123], v[40:43], v[104:107], v[120:123]
  v_mfma_f32_16x16x32_bf16 v[124:127], v[40:43], v[108:111], v[124:127]
  v_mfma_f32_16x16x32_bf16 v[128:131], v[40:43], v[112:115], v[128:131]
  v_mfma_f32_16x16x32_bf16 v[132:135], v[40:43], v[116:119], v[132:135]
  s_nop 5
  v_cndmask_b32 v120, v120, v124, s[82:83]
  v_cndmask_b32 v120, v120, v128, s[84:85]
  v_cndmask_b32 v120, v120, v132, s[86:87]
  v_cndmask_b32 v121, v121, v125, s[82:83]
  v_cndmask_b32 v121, v121, v129, s[84:85]
  v_cndmask_b32 v121, v121, v133, s[86:87]
  v_mov_b32 v136, v120
  v_mov_b32_dpp v138, v120 quad_perm:[1,1,3,3] row_mask:0xf bank_mask:0xf
  v_mov_b32 v137, s12
  v_mov_b32 v139, s12
  v_mov_b32 v140, v121
  v_mov_b32_dpp v142, v121 quad_perm:[1,1,3,3] row_mask:0xf bank_mask:0xf
  v_mov_b32 v141, s12
  v_mov_b32 v143, s12
  v_lshrrev_b32 v14, 3, v1
  v_lshlrev_b32 v14, 14, v14
  v_and_b32 v15, 7, v1
  v_lshl_add_u32 v14, v15, 7, v14
  s_lshl_b32 s13, s5, 10
  s_add_u32 s13, s13, 2064384
  s_waitcnt vmcnt(6)
  ds_read_b64_tr_b16 v[56:57], v9 offset:16384
  ds_read_b64_tr_b16 v[58:59], v9 offset:16896
  ds_read_b64_tr_b16 v[60:61], v10 offset:16384
  ds_read_b64_tr_b16 v[62:63], v10 offset:16896
  ds_read_b64_tr_b16 v[64:65], v11 offset:16384
  ds_read_b64_tr_b16 v[66:67], v11 offset:16896
  ds_read_b64_tr_b16 v[68:69], v12 offset:16384
  ds_read_b64_tr_b16 v[70:71], v12 offset:16896
  s_waitcnt vmcnt(2)
  ds_read_b64_tr_b16 v[72:73], v9 offset:20480
  ds_read_b64_tr_b16 v[74:75], v9 offset:20992
  ds_read_b64_tr_b16 v[76:77], v10 offset:20480
  ds_read_b64_tr_b16 v[78:79], v10 offset:20992
  ds_read_b64_tr_b16 v[80:81], v11 offset:20480
  ds_read_b64_tr_b16 v[82:83], v11 offset:20992
  ds_read_b64_tr_b16 v[84:85], v12 offset:20480
  ds_read_b64_tr_b16 v[86:87], v12 offset:20992
  s_waitcnt lgkmcnt(8)
  v_mfma_f32_16x16x32_bf16 v[120:123], v[44:47], v[56:59], 0
  v_mfma_f32_16x16x32_bf16 v[124:127], v[44:47], v[60:63], 0
  v_mfma_f32_16x16x32_bf16 v[128:131], v[44:47], v[64:67], 0
  v_mfma_f32_16x16x32_bf16 v[132:135], v[44:47], v[68:71], 0
  s_waitcnt lgkmcnt(0)
  v_mfma_f32_16x16x32_bf16 v[120:123], v[48:51], v[72:75], v[120:123]
  v_mfma_f32_16x16x32_bf16 v[124:127], v[48:51], v[76:79], v[124:127]
  v_mfma_f32_16x16x32_bf16 v[128:131], v[48:51], v[80:83], v[128:131]
  v_mfma_f32_16x16x32_bf16 v[132:135], v[48:51], v[84:87], v[132:135]
  s_nop 5
  v_cndmask_b32 v120, v120, v124, s[82:83]
  v_cndmask_b32 v120, v120, v128, s[84:85]
  v_cndmask_b32 v120, v120, v132, s[86:87]
  v_cndmask_b32 v121, v121, v125, s[82:83]
  v_cndmask_b32 v121, v121, v129, s[84:85]
  v_cndmask_b32 v121, v121, v133, s[86:87]
  v_mov_b32 v144, v120
  v_mov_b32_dpp v146, v120 quad_perm:[1,1,3,3] row_mask:0xf bank_mask:0xf
  v_mov_b32 v145, s12
  v_mov_b32 v147, s12
  v_mov_b32 v148, v121
  v_mov_b32_dpp v150, v121 quad_perm:[1,1,3,3] row_mask:0xf bank_mask:0xf
  v_mov_b32 v149, s12
  v_mov_b32 v151, s12
  s_waitcnt vmcnt(0)
  s_mov_b64 exec, 0xffff
  buffer_load_dwordx4 v[156:159], v14, s[52:55], s13 offen sc1
  s_mov_b64 exec, -1
  s_mov_b32 s77, 3
  s_mov_b64 exec, 0xffff
L_an:
  s_waitcnt vmcnt(0)
  v_cmp_eq_u32 s[80:81], s78, v156
  v_cmp_eq_u32 s[82:83], s12, v157
  v_cmp_eq_u32 s[84:85], s78, v158
  v_cmp_eq_u32 s[86:87], s12, v159
  s_and_b64 s[80:81], s[80:81], s[82:83]
  s_and_b64 s[84:85], s[84:85], s[86:87]
  s_and_b64 s[80:81], s[80:81], s[84:85]
  s_cmp_eq_u32 s80, 0xffff
  s_cbranch_scc1 L_an_done
  s_sub_u32 s77, s77, 1
  s_cbranch_scc1 L_an_fail
  buffer_load_dwordx4 v[156:159], v14, s[52:55], s13 offen sc1
  s_branch L_an
L_an_fail:
  s_cmp_eq_u32 s80, 0xffff
L_an_done:
  s_cselect_b32 s78, 1, 0
  s_mov_b64 exec, -1
  s_mov_b32 exec_lo, 0x55555555
  s_mov_b32 exec_hi, 0x55555555
  s_cmp_eq_u32 s78, 1
  s_cbranch_scc1 L_xl2
  buffer_store_dwordx4 v[136:139], v17, s[52:55], s8 offen sc1
  buffer_store_dwordx4 v[140:143], v17, s[52:55], s9 offen sc1
  s_branch L_xd2
L_xl2:
  buffer_store_dwordx4 v[136:139], v17, s[52:55], s8 offen
  buffer_store_dwordx4 v[140:143], v17, s[52:55], s9 offen
L_xd2:
  s_mov_b64 exec, -1
  s_cmp_eq_u32 s79, 0
  s_cbranch_scc1 L_sv_noh
  s_add_u32 s9, s11, 114688
  s_mov_b32 exec_lo, 0x55555555
  s_mov_b32 exec_hi, 0x55555555
  s_cmp_eq_u32 s78, 1
  s_cbranch_scc1 L_xl3
  buffer_store_dwordx4 v[144:147], v17, s[52:55], s11 offen sc1
  buffer_store_dwordx4 v[148:151], v17, s[52:55], s9 offen sc1
  s_branch L_xd3
L_xl3:
  buffer_store_dwordx4 v[144:147], v17, s[52:55], s11 offen
  buffer_store_dwordx4 v[148:151], v17, s[52:55], s9 offen
L_xd3:
  s_mov_b64 exec, -1
L_sv_noh:
  v_mov_b32 v14, 0
  s_mov_b32 s80, 4194304
L_wait_pg1:
  ds_read_b32 v15, v14 offset:27276
  s_waitcnt lgkmcnt(0)
  v_readfirstlane_b32 s81, v15
  s_nop 0
  s_cmp_ge_u32 s81, 16
  s_cbranch_scc1 L_got_pg1
  s_sleep 4
  s_sub_u32 s80, s80, 1
  s_cmp_lg_u32 s80, 0
  s_cbranch_scc1 L_wait_pg1
L_got_pg1:
  s_lshl_b32 s8, s7, 13
  s_add_u32 s8, s8, 262144
  s_add_u32 s9, s8, 4096
  s_mov_b32 s40, -1
  s_mov_b32 s41, -1
  s_mov_b32 s42, -1
  s_mov_b32 s43, -1
  s_mov_b32 s44, -1
  s_mov_b32 s45, -1
  s_mov_b32 s46, -1
  s_mov_b32 s47, -1
  s_mov_b32 s48, -1
  s_mov_b32 s49, -1
  s_mov_b32 s50, -1
  s_mov_b32 s51, -1
  s_mov_b32 s82, -1
  s_mov_b32 s83, -1
  s_mov_b32 s84, -1
  s_mov_b32 s85, -1
  s_mov_b32 s80, 524288
L_g_q:
  s_mov_b64 exec, s[40:41]
  s_cbranch_execz L_g_q_s0
  buffer_load_dwordx4 v[56:59], v2, s[52:55], s8 offen offset:0 sc1
L_g_q_s0:
  s_mov_b64 exec, s[42:43]
  s_cbranch_execz L_g_q_s1
  buffer_load_dwordx4 v[60:63], v2, s[52:55], s8 offen offset:1024 sc1
L_g_q_s1:
  s_mov_b64 exec, s[44:45]
  s_cbranch_execz L_g_q_s2
  buffer_load_dwordx4 v[64:67], v2, s[52:55], s8 offen offset:2048 sc1
L_g_q_s2:
  s_mov_b64 exec, s[46:47]
  s_cbranch_execz L_g_q_s3
  buffer_load_dwordx4 v[68:71], v2, s[52:55], s8 offen offset:3072 sc1
L_g_q_s3:
  s_mov_b64 exec, s[48:49]
  s_cbranch_execz L_g_q_s4
  buffer_load_dwordx4 v[72:75], v2, s[52:55], s9 offen offset:0 sc1
L_g_q_s4:
  s_mov_b64 exec, s[50:51]
  s_cbranch_execz L_g_q_s5
  buffer_load_dwordx4 v[76:79], v2, s[52:55], s9 offen offset:1024 sc1
L_g_q_s5:
  s_mov_b64 exec, s[82:83]
  s_cbranch_execz L_g_q_s6
  buffer_load_dwordx4 v[80:83], v2, s[52:55], s9 offen offset:2048 sc1
L_g_q_s6:
  s_mov_b64 exec, s[84:85]
  s_cbranch_execz L_g_q_s7
  buffer_load_dwordx4 v[84:87], v2, s[52:55], s9 offen offset:3072 sc1
L_g_q_s7:
  s_waitcnt vmcnt(0)
  s_mov_b64 exec, s[40:41]
  v_cmp_ne_u32 vcc, s12, v57
  v_cmp_ne_u32 s[40:41], s12, v59
  s_nop 0
  s_or_b64 s[40:41], s[40:41], vcc
  s_mov_b64 s[14:15], s[40:41]
  s_mov_b64 exec, s[42:43]
  v_cmp_ne_u32 vcc, s12, v61
  v_cmp_ne_u32 s[42:43], s12, v63
  s_nop 0
  s_or_b64 s[42:43], s[42:43], vcc
  s_or_b64 s[14:15], s[14:15], s[42:43]
  s_mov_b64 exec, s[44:45]
  v_cmp_ne_u32 vcc, s12, v65
  v_cmp_ne_u32 s[44:45], s12, v67
  s_nop 0
  s_or_b64 s[44:45], s[44:45], vcc
  s_or_b64 s[14:15], s[14:15], s[44:45]
  s_mov_b64 exec, s[46:47]
  v_cmp_ne_u32 vcc, s12, v69
  v_cmp_ne_u32 s[46:47], s12, v71
  s_nop 0
  s_or_b64 s[46:47], s[46:47], vcc
  s_or_b64 s[14:15], s[14:15], s[46:47]
  s_mov_b64 exec, s[48:49]
  v_cmp_ne_u32 vcc, s12, v73
  v_cmp_ne_u32 s[48:49], s12, v75
  s_nop 0
  s_or_b64 s[48:49], s[48:49], vcc
  s_or_b64 s[14:15], s[14:15], s[48:49]
  s_mov_b64 exec, s[50:51]
  v_cmp_ne_u32 vcc, s12, v77
  v_cmp_ne_u32 s[50:51], s12, v79
  s_nop 0
  s_or_b64 s[50:51], s[50:51], vcc
  s_or_b64 s[14:15], s[14:15], s[50:51]
  s_mov_b64 exec, s[82:83]
  v_cmp_ne_u32 vcc, s12, v81
  v_cmp_ne_u32 s[82:83], s12, v83
  s_nop 0
  s_or_b64 s[82:83], s[82:83], vcc
  s_or_b64 s[14:15], s[14:15], s[82:83]
  s_mov_b64 exec, s[84:85]
  v_cmp_ne_u32 vcc, s12, v85
  v_cmp_ne_u32 s[84:85], s12, v87
  s_nop 0
  s_or_b64 s[84:85], s[84:85], vcc
  s_or_b64 s[14:15], s[14:15], s[84:85]
  s_cmp_eq_u64 s[14:15], 0
  s_cbranch_scc1 L_g_q_ok
  s_sleep 2
  s_sub_u32 s80, s80, 1
  s_cmp_lg_u32 s80, 0
  s_cbranch_scc1 L_g_q
L_g_q_ok:
  s_mov_b64 exec, -1
  v_add_f32 v56, v56, v64
  v_add_f32 v72, v72, v80
  v_add_f32 v58, v58, v66
  v_add_f32 v74, v74, v82
  v_add_f32 v56, v56, v72
  v_add_f32 v58, v58, v74
  v_cvt_pk_bf16_f32 v56, v56, v58
  v_add_f32 v60, v60, v68
  v_add_f32 v76, v76, v84
  v_add_f32 v62, v62, v70
  v_add_f32 v78, v78, v86
  v_add_f32 v60, v60, v76
  v_add_f32 v62, v62, v78
  v_cvt_pk_bf16_f32 v60, v60, v62
  v_lshlrev_b32 v14, 2, v1
  ds_write_b32 v14, v56 offset:26624
  ds_write_b32 v14, v60 offset:26880
  v_mov_b32 v14, 0
  v_mov_b32 v15, s12
  v_mov_b32 v16, 1
  ds_write_b32 v14, v15 offset:27216
  ds_write_b32 v14, v16 offset:27264
  s_mul_i32 s14, s4, 896
  v_add_u32 v14, s14, v2
  ds_read_b128 v[28:31], v14 offset:24576
  s_waitcnt lgkmcnt(0)
  v_mov_b32 v20, 0
  v_lshlrev_b32 v14, 16, v28
  v_and_b32 v15, 0xffff0000, v28
  v_lshlrev_b32 v16, 16, v24
  v_and_b32 v17, 0xffff0000, v24
  v_mul_f32 v14, v14, v16
  v_mul_f32 v15, v15, v17
  v_cvt_pk_bf16_f32 v14, v14, v15
  v_lshlrev_b32 v15, 16, v14
  v_and_b32 v14, 0xffff0000, v14
  v_add_f32 v20, v20, v15
  v_add_f32 v20, v20, v14
  v_lshlrev_b32 v14, 16, v29
  v_and_b32 v15, 0xffff0000, v29
  v_lshlrev_b32 v16, 16, v25
  v_and_b32 v17, 0xffff0000, v25
  v_mul_f32 v14, v14, v16
  v_mul_f32 v15, v15, v17
  v_cvt_pk_bf16_f32 v14, v14, v15
  v_lshlrev_b32 v15, 16, v14
  v_and_b32 v14, 0xffff0000, v14
  v_add_f32 v20, v20, v15
  v_add_f32 v20, v20, v14
  v_lshlrev_b32 v14, 16, v30
  v_and_b32 v15, 0xffff0000, v30
  v_lshlrev_b32 v16, 16, v26
  v_and_b32 v17, 0xffff0000, v26
  v_mul_f32 v14, v14, v16
  v_mul_f32 v15, v15, v17
  v_cvt_pk_bf16_f32 v14, v14, v15
  v_lshlrev_b32 v15, 16, v14
  v_and_b32 v14, 0xffff0000, v14
  v_add_f32 v20, v20, v15
  v_add_f32 v20, v20, v14
  v_lshlrev_b32 v14, 16, v31
  v_and_b32 v15, 0xffff0000, v31
  v_lshlrev_b32 v16, 16, v27
  v_and_b32 v17, 0xffff0000, v27
  v_mul_f32 v14, v14, v16
  v_mul_f32 v15, v15, v17
  v_cvt_pk_bf16_f32 v14, v14, v15
  v_lshlrev_b32 v15, 16, v14
  v_and_b32 v14, 0xffff0000, v14
  v_add_f32 v20, v20, v15
  v_add_f32 v20, v20, v14
  v_cmp_gt_u32 vcc, 56, v1
  s_nop 1
  v_cndmask_b32 v20, 0, v20, vcc
  s_nop 1
  v_add_f32_dpp v20, v20, v20 quad_perm:[1,0,3,2] row_mask:0xf bank_mask:0xf
  s_nop 1
  v_add_f32_dpp v20, v20, v20 quad_perm:[2,3,0,1] row_mask:0xf bank_mask:0xf
  s_nop 1
  v_add_f32_dpp v20, v20, v20 row_half_mirror row_mask:0xf bank_mask:0xf
  s_nop 1
  v_add_f32_dpp v20, v20, v20 row_mirror row_mask:0xf bank_mask:0xf
  v_mov_b32 v14, v20
  s_nop 1
  v_permlane16_swap_b32 v20, v14
  v_add_f32 v20, v20, v14
  v_mov_b32 v14, v20
  s_nop 1
  v_permlane32_swap_b32 v20, v14
  v_add_f32 v20, v20, v14
  v_cvt_pk_bf16_f32 v20, v20, v20
  v_lshlrev_b32 v20, 16, v20
  v_mul_f32 v20, 0xbfb8aa3b, v20
  v_exp_f32 v20, v20
  s_nop 0
  v_add_f32 v20, 1.0, v20
  v_rcp_f32 v20, v20
  s_nop 0
  v_cvt_pk_bf16_f32 v20, v20, v20
  v_lshlrev_b32 v20, 16, v20
  v_sub_f32 v21, 1.0, v20
  v_cvt_pk_bf16_f32 v21, v21, v21
  v_lshlrev_b32 v21, 16, v21
  v_mov_b32 v14, 0
  s_mov_b32 s80, 4194304
L_wait_cnt:
  ds_read_b32 v15, v14 offset:27272
  s_waitcnt lgkmcnt(0)
  v_readfirstlane_b32 s81, v15
  s_nop 0
  s_cmp_eq_u32 s81, 8
  s_cbranch_scc1 L_got_cnt
  s_sleep 2
  s_sub_u32 s80, s80, 1
  s_cmp_lg_u32 s80, 0
  s_cbranch_scc1 L_wait_cnt
L_got_cnt:
  v_and_b32 v16, 7, v1
  v_lshlrev_b32 v16, 3, v16
  ds_read_b64 v[36:37], v16 offset:27328
  s_waitcnt lgkmcnt(0)
  v_mov_b32 v14, v36
  s_nop 1
  v_max_f32_dpp v14, v14, v14 quad_perm:[1,0,3,2] row_mask:0xf bank_mask:0xf
  s_nop 1
  v_max_f32_dpp v14, v14, v14 quad_perm:[2,3,0,1] row_mask:0xf bank_mask:0xf
  s_nop 1
  v_max_f32_dpp v14, v14, v14 row_half_mirror row_mask:0xf bank_mask:0xf
  v_sub_f32 v15, v36, v14
  v_exp_f32 v15, v15
  s_nop 0
  v_mul_f32 v15, v15, v37
  s_nop 1
  v_add_f32_dpp v15, v15, v15 quad_perm:[1,0,3,2] row_mask:0xf bank_mask:0xf
  s_nop 1
  v_add_f32_dpp v15, v15, v15 quad_perm:[2,3,0,1] row_mask:0xf bank_mask:0xf
  s_nop 1
  v_add_f32_dpp v15, v15, v15 row_half_mirror row_mask:0xf bank_mask:0xf
  v_mov_b32 v32, v14
  v_mov_b32 v33, s12
  v_mov_b32 v34, v15
  v_mov_b32 v35, s12
  s_lshl_b32 s11, s7, 10
  s_add_u32 s11, s11, 2031616
  s_lshl_b32 s9, s6, 7
  s_add_u32 s9, s9, s11
  s_mov_b64 exec, 0xff
  s_cmp_eq_u32 s78, 1
  s_cbranch_scc1 L_xl4
  buffer_store_dwordx4 v[32:35], v2, s[52:55], s9 offen sc1
  s_branch L_xd4
L_xl4:
  buffer_store_dwordx4 v[32:35], v2, s[52:55], s9 offen
L_xd4:
  s_mov_b64 exec, -1
  v_mov_b32 v14, 0
  s_mov_b32 s80, 4194304
L_wait_pg2:
  ds_read_b32 v15, v14 offset:27276
  s_waitcnt lgkmcnt(0)
  v_readfirstlane_b32 s81, v15
  s_nop 0
  s_cmp_ge_u32 s81, 46
  s_cbranch_scc1 L_got_pg2
  s_sleep 8
  s_sub_u32 s80, s80, 1
  s_cmp_lg_u32 s80, 0
  s_cbranch_scc1 L_wait_pg2
L_got_pg2:
  v_mov_b32 v28, 0
  v_mov_b32 v30, 0
  s_cmp_ge_u32 s10, 112
  s_cbranch_scc1 L_sv_hz
  v_lshrrev_b32 v14, 3, v1
  v_lshlrev_b32 v14, 9, v14
  v_and_b32 v15, 7, v1
  v_lshl_add_u32 v14, v15, 4, v14
  s_lshr_b32 s8, s10, 2
  s_mul_i32 s9, s4, 28
  s_add_u32 s8, s8, s9
  s_mul_i32 s8, s8, 4096
  s_and_b32 s9, s10, 3
  s_lshl_b32 s9, s9, 7
  s_add_u32 s8, s8, s9
  s_add_u32 s8, s8, 32768
  s_mov_b32 s82, -1
  s_mov_b32 s83, 0x00ffffff
  s_mov_b32 s80, 524288
L_g_h:
  s_mov_b64 exec, s[82:83]
  buffer_load_dwordx4 v[28:31], v14, s[52:55], s8 offen offset:0 sc1
  s_waitcnt vmcnt(0)
  v_cmp_ne_u32 vcc, s12, v29
  v_cmp_ne_u32 s[82:83], s12, v31
  s_nop 0
  s_or_b64 s[82:83], s[82:83], vcc
  s_mov_b64 s[14:15], s[82:83]
  s_cmp_eq_u64 s[14:15], 0
  s_cbranch_scc1 L_g_h_ok
  s_sleep 2
  s_sub_u32 s80, s80, 1
  s_cmp_lg_u32 s80, 0
  s_cbranch_scc1 L_g_h
L_g_h_ok:
  s_mov_b64 exec, -1
L_sv_hz:
  v_add_f32_dpp v28, v28, v28 row_ror:8 row_mask:0xf bank_mask:0xf
  v_add_f32_dpp v30, v30, v30 row_ror:8 row_mask:0xf bank_mask:0xf
  v_mov_b32 v29, v28
  v_mov_b32 v31, v30
  s_nop 0
  v_permlane16_swap_b32 v28, v29
  v_permlane16_swap_b32 v30, v31
  v_add_f32 v28, v28, v29
  v_add_f32 v30, v30, v31
  v_mov_b32 v29, v28
  v_mov_b32 v31, v30
  s_nop 0
  v_permlane32_swap_b32 v28, v29
  v_permlane32_swap_b32 v30, v31
  v_add_f32 v28, v28, v29
  v_add_f32 v30, v30, v31
  v_max_f32 v28, 0, v28
  v_max_f32 v30, 0, v30
  v_cvt_pk_bf16_f32 v28, v28, v28
  v_cvt_pk_bf16_f32 v29, v30, v30
  v_lshlrev_b32 v14, 3, v1
  s_mov_b64 exec, 0xff
  ds_write_b64 v14, v[28:29] offset:27136
  s_mov_b64 exec, -1
  v_lshlrev_b32 v16, 7, v1
  s_mov_b32 s82, 0xff
  s_mov_b32 s83, 0
  s_mov_b32 s80, 524288
L_g_st:
  s_mov_b64 exec, s[82:83]
  buffer_load_dwordx4 v[36:39], v16, s[52:55], s11 offen offset:0 sc1
  s_waitcnt vmcnt(0)
  v_cmp_ne_u32 vcc, s12, v37
  v_cmp_ne_u32 s[82:83], s12, v39
  s_nop 0
  s_or_b64 s[82:83], s[82:83], vcc
  s_mov_b64 s[14:15], s[82:83]
  s_cmp_eq_u64 s[14:15], 0
  s_cbranch_scc1 L_g_st_ok
  s_sleep 8
  s_sub_u32 s80, s80, 1
  s_cmp_lg_u32 s80, 0
  s_cbranch_scc1 L_g_st
L_g_st_ok:
  s_mov_b64 exec, -1
  v_mov_b32 v14, v36
  s_nop 1
  v_max_f32_dpp v14, v14, v14 quad_perm:[1,0,3,2] row_mask:0xf bank_mask:0xf
  s_nop 1
  v_max_f32_dpp v14, v14, v14 quad_perm:[2,3,0,1] row_mask:0xf bank_mask:0xf
  s_nop 1
  v_max_f32_dpp v14, v14, v14 row_half_mirror row_mask:0xf bank_mask:0xf
  v_sub_f32 v15, v36, v14
  v_exp_f32 v15, v15
  s_nop 0
  v_mul_f32 v15, v15, v38
  s_nop 1
  v_add_f32_dpp v15, v15, v15 quad_perm:[1,0,3,2] row_mask:0xf bank_mask:0xf
  s_nop 1
  v_add_f32_dpp v15, v15, v15 quad_perm:[2,3,0,1] row_mask:0xf bank_mask:0xf
  s_nop 1
  v_add_f32_dpp v15, v15, v15 row_half_mirror row_mask:0xf bank_mask:0xf
  v_sub_f32 v22, 0, v14
  v_rcp_f32 v23, v15
  s_nop 0
  v_mul_f32 v23, v23, v20
  v_mov_b32 v20, s78
  v_mov_b32 v14, 0
  v_mov_b32 v15, 1
  s_mov_b64 exec, 1
  ds_write_b128 v14, v[20:23] offset:27200
  ds_write_b32 v14, v15 offset:27268
  s_mov_b64 exec, -1
  s_waitcnt lgkmcnt(0)
L_end:
  s_endpgm
.section .rodata,"a"
.p2align 6
.amdhsa_kernel gated_mix__mha_block_cached__dense_activation_relu__decode_kernel
  .amdhsa_next_free_vgpr 168
  .amdhsa_next_free_sgpr 96
  .amdhsa_accum_offset 168
  .amdhsa_group_segment_fixed_size 0
  .amdhsa_kernarg_size 96
  .amdhsa_user_sgpr_count 2
  .amdhsa_user_sgpr_kernarg_segment_ptr 1
  .amdhsa_system_sgpr_workgroup_id_x 1
.end_amdhsa_kernel
```
